```python
import torch

def _softmax(x, axis=-1):
    return torch.softmax(x, dim=axis)
def _gelu(x):
    return torch.nn.functional.gelu(x, approximate="tanh")
def _silu(x):
    return torch.nn.functional.silu(x)
def _sigmoid(x):
    return torch.sigmoid(x)
def _layernorm(x, axis=-1, eps=1e-5):
    m = x.mean(dim=axis, keepdim=True)
    v = x.var(dim=axis, keepdim=True, unbiased=False)
    return (x - m) / torch.sqrt(v + eps)
def _scatter_add(tgt, idx, src, axis=0):
    return tgt.clone().index_add_(axis, idx, src)
def _segment_sum(src, seg, n):
    out = torch.zeros((n,) + src.shape[1:], dtype=src.dtype)
    return out.index_add_(0, seg, src)
def _pad(x, pw):
    flat = tuple(v for pair in reversed(pw) for v in pair)
    return torch.nn.functional.pad(x, flat)

kernel_name = 'recurrent_scan__sliding_block_cached__mixer_channel_mlp__decode'

def setup_inputs():

    _w = (lambda a: (lambda t: t.to(torch.bfloat16) if t.is_floating_point() else t)(torch.as_tensor(a)))
    def _A_setup():
        B, Sq, D = 1, 1, 512
        Hq, Hkv, Sk, Dh = 32, 32, 8192, 128
        assert Hq % Hkv == 0, (Hq, Hkv)
        return {
            "x": _w((lambda *s: torch.randn(*s, dtype=torch.bfloat16) * 0.05)(B, Sq, D)),
            "k_cache": _w((lambda *s: torch.randn(*s, dtype=torch.bfloat16) * 3.2)(B, Hkv, Sk, Dh)),
            "v_cache": _w((lambda *s: torch.randn(*s, dtype=torch.bfloat16) * 3.2)(B, Hkv, Sk, Dh)),
            "wq": _w((lambda *s: torch.randn(*s, dtype=torch.bfloat16) * 3.2)(D, Hq * Dh) * (D ** -0.5)),
            "wo": _w((lambda *s: torch.randn(*s, dtype=torch.bfloat16) * 3.2)(Hq * Dh, D) * ((Hq * Dh) ** -0.5)),
        }
    _A_in = _A_setup()

    def _B_setup():
        B, S, D, F = 1, 1, 512, 1376
        return {
            "x": _w((lambda *s: torch.randn(*s, dtype=torch.bfloat16) * 0.05)(B, S, D)),
            "w1": _w((lambda *s: torch.randn(*s, dtype=torch.bfloat16) * 3.2)(D, F) * (D ** -0.5)),
            "b1": _w((lambda *s: torch.randn(*s, dtype=torch.bfloat16) * 3.2)(F)),
            "w2": _w((lambda *s: torch.randn(*s, dtype=torch.bfloat16) * 0.4)(F, D) * (F ** -0.5)),
            "b2": _w((lambda *s: torch.randn(*s, dtype=torch.bfloat16) * 0.4)(D)),
        }
    _B_in = _B_setup()

    return {
        "A_x": _A_in["x"],
        "A_k_cache": _A_in["k_cache"],
        "A_v_cache": _A_in["v_cache"],
        "A_wq": _A_in["wq"],
        "A_wo": _A_in["wo"],
        "B_x": _B_in["x"],
        "B_w1": _B_in["w1"],
        "B_b1": _B_in["b1"],
        "B_w2": _B_in["w2"],
        "B_b2": _B_in["b2"],
    }

def reference(A_x, A_k_cache, A_v_cache, A_wq, A_wo, B_x, B_w1, B_b1, B_w2, B_b2):
    def _A_ref(x, k_cache, v_cache, wq, wo):
        B, Sq, D = x.shape
        Hq, Dh = 32, 128
        Hkv, Sk = k_cache.shape[1], k_cache.shape[2]
        W = min(4096, max(256, Sk // 4))
        rep = Hq // Hkv
        q = (lambda x, *d: x.permute(*d))((x @ wq).reshape(B, Sq, Hq, Dh), 0, 2, 1, 3)
        k = (lambda x, n, axis: torch.repeat_interleave(x, n, dim=axis))(k_cache[:, :, Sk - W:, :], rep, axis=1)
        v = (lambda x, n, axis: torch.repeat_interleave(x, n, dim=axis))(v_cache[:, :, Sk - W:, :], rep, axis=1)
        scores = torch.einsum("bhqd,bhkd->bhqk", q, k) * (Dh ** -0.5)
        p = _softmax(scores, axis=-1)
        o = torch.einsum("bhqk,bhkd->bhqd", p, v)
        return (lambda x, *d: x.permute(*d))(o, 0, 2, 1, 3).reshape(B, Sq, Hq * Dh) @ wo

    def _B_ref(x, w1, b1, w2, b2):
        y = _layernorm(x, axis=-1)
        h = _gelu(torch.einsum("bsd,df->bsf", y, w1) + b1)
        return torch.einsum("bsf,fd->bsd", h, w2) + b2

    x = A_x
    xn = _layernorm(x, axis=-1)
    s = _A_ref(xn, A_k_cache, A_v_cache, A_wq, A_wo)
    g = _silu(_B_ref(xn, B_w1, B_b1, B_w2, B_b2))
    return x + s * g
```

```asm
; @launch grid=(256,1,1) block=(384,1,1) lds=8192
.amdgcn_target "amdgcn-amd-amdhsa--gfx950"
.text
.globl recurrent_scan__sliding_block_cached__mixer_channel_mlp__decode_kernel
.p2align 8
.type recurrent_scan__sliding_block_cached__mixer_channel_mlp__decode_kernel,@function
recurrent_scan__sliding_block_cached__mixer_channel_mlp__decode_kernel:
    s_load_dwordx16 s[8:23], s[0:1], 0
    s_load_dwordx8 s[24:31], s[0:1], 64
    s_load_dwordx2 s[32:33], s[0:1], 96
    v_readfirstlane_b32 s3, v0
    s_cmp_ge_u32 s2, 256
    s_cbranch_scc1 L_end
    s_and_b32 s4, s2, 31
    s_lshr_b32 s5, s2, 5
    v_and_b32 v1, 63, v0
    s_cmp_lt_u32 s3, 64
    s_cbranch_scc1 L_aux
    s_cmp_lt_u32 s3, 320
    s_cbranch_scc1 L_stream
    s_getpc_b64 s[36:37]
L_pc:
    s_bfe_u32 s35, s2, 0x30003
    s_mul_i32 s35, s35, 1280
    v_lshl_add_u32 v2, v1, 7, s35
    v_min_u32 v2, L_codeend-L_pc-4, v2
    s_mov_b64 exec, 0x3ff
    global_load_dword v2, v2, s[36:37]
    s_barrier
    s_mov_b32 s6, 0
    s_mov_b64 s[54:55], 0
    s_waitcnt vmcnt(0) lgkmcnt(0)
    s_mov_b64 exec, 0
    s_branch L_warm1
L_aux:
    s_setprio 3
    s_lshr_b32 s58, s2, 3
    s_and_b32 s59, s2, 7
    v_and_b32 v2, 15, v1
    v_lshrrev_b32 v3, 4, v1
    v_lshlrev_b32 v10, 4, v1
    s_lshl_b32 s6, s59, 7
    v_lshlrev_b32 v11, 1, v3
    v_lshl_or_b32 v11, v2, 3, v11
    v_add_u32 v8, s6, v11
    s_lshl_b32 s7, s59, 19
    s_lshl_b32 s35, s58, 8
    s_add_u32 s7, s7, s35
    v_lshlrev_b32 v12, 4, v2
    v_lshl_or_b32 v13, v3, 13, v12
    v_add_u32 v16, s7, v13
    s_mov_b32 s38, 0x8000
    s_waitcnt lgkmcnt(0)
    global_load_dwordx4 v[4:7], v10, s[8:9]
    global_load_ushort v8, v8, s[8:9]
    s_load_dword s34, s[32:33], 0
    v_add_u32 v20, s38, v16
    global_load_dwordx4 v[16:19], v16, s[14:15] nt
    v_add_u32 v24, s38, v20
    global_load_dwordx4 v[20:23], v20, s[14:15] nt
    v_add_u32 v28, s38, v24
    global_load_dwordx4 v[24:27], v24, s[14:15] nt
    v_add_u32 v32, s38, v28
    global_load_dwordx4 v[28:31], v28, s[14:15] nt
    v_add_u32 v36, s38, v32
    global_load_dwordx4 v[32:35], v32, s[14:15] nt
    v_add_u32 v40, s38, v36
    global_load_dwordx4 v[36:39], v36, s[14:15] nt
    v_add_u32 v44, s38, v40
    global_load_dwordx4 v[40:43], v40, s[14:15] nt
    v_add_u32 v48, s38, v44
    global_load_dwordx4 v[44:47], v44, s[14:15] nt
    v_add_u32 v52, s38, v48
    global_load_dwordx4 v[48:51], v48, s[14:15] nt
    v_add_u32 v56, s38, v52
    global_load_dwordx4 v[52:55], v52, s[14:15] nt
    v_add_u32 v60, s38, v56
    global_load_dwordx4 v[56:59], v56, s[14:15] nt
    v_add_u32 v64, s38, v60
    global_load_dwordx4 v[60:63], v60, s[14:15] nt
    v_add_u32 v68, s38, v64
    global_load_dwordx4 v[64:67], v64, s[14:15] nt
    v_add_u32 v72, s38, v68
    global_load_dwordx4 v[68:71], v68, s[14:15] nt
    v_add_u32 v76, s38, v72
    global_load_dwordx4 v[72:75], v72, s[14:15] nt
    global_load_dwordx4 v[76:79], v76, s[14:15] nt
    s_mul_i32 s35, s58, 43
    s_lshr_b32 s35, s35, 3
    s_lshl_b32 s35, s35, 4
    s_mul_i32 s7, s59, 176128
    s_add_u32 s7, s7, s35
    s_mul_i32 s36, s4, 43
    s_add_u32 s37, s36, 43
    s_lshr_b32 s36, s36, 3
    s_lshr_b32 s37, s37, 3
    s_sub_u32 s37, s37, s36
    s_lshl_b32 s35, s36, 4
    s_lshl_b32 s6, s5, 7
    v_mul_u32_u24 v13, 2752, v3
    v_add3_u32 v80, v13, v12, s7
    v_lshl_or_b32 v203, v3, 2, v12
    v_and_b32 v9, 7, v2
    v_min_u32 v9, 5, v9
    v_lshlrev_b32 v9, 4, v9
    v_lshl_or_b32 v9, v3, 2, v9
    v_lshrrev_b32 v13, 3, v2
    v_lshl_or_b32 v9, v13, 1, v9
    v_add_u32 v9, s35, v9
    s_lshl_b32 s7, s36, 13
    s_add_u32 s7, s7, s6
    v_lshrrev_b32 v13, 3, v2
    v_lshl_or_b32 v13, v3, 1, v13
    v_lshlrev_b32 v13, 10, v13
    v_and_b32 v14, 7, v2
    v_lshl_or_b32 v13, v14, 4, v13
    v_add_u32 v144, s7, v13
    s_movk_i32 s38, 11008
    s_movk_i32 s39, 8192
    s_mov_b32 s54, 0x003f003f
    s_mov_b32 s55, s54
    s_mov_b64 exec, s[54:55]
    v_add_u32 v84, s38, v80
    global_load_dwordx4 v[80:83], v80, s[20:21] nt
    v_add_u32 v88, s38, v84
    global_load_dwordx4 v[84:87], v84, s[20:21] nt
    v_add_u32 v92, s38, v88
    global_load_dwordx4 v[88:91], v88, s[20:21] nt
    v_add_u32 v96, s38, v92
    global_load_dwordx4 v[92:95], v92, s[20:21] nt
    v_add_u32 v100, s38, v96
    global_load_dwordx4 v[96:99], v96, s[20:21] nt
    v_add_u32 v104, s38, v100
    global_load_dwordx4 v[100:103], v100, s[20:21] nt
    v_add_u32 v108, s38, v104
    global_load_dwordx4 v[104:107], v104, s[20:21] nt
    v_add_u32 v112, s38, v108
    global_load_dwordx4 v[108:111], v108, s[20:21] nt
    v_add_u32 v116, s38, v112
    global_load_dwordx4 v[112:115], v112, s[20:21] nt
    v_add_u32 v120, s38, v116
    global_load_dwordx4 v[116:119], v116, s[20:21] nt
    v_add_u32 v124, s38, v120
    global_load_dwordx4 v[120:123], v120, s[20:21] nt
    v_add_u32 v128, s38, v124
    global_load_dwordx4 v[124:127], v124, s[20:21] nt
    v_add_u32 v132, s38, v128
    global_load_dwordx4 v[128:131], v128, s[20:21] nt
    v_add_u32 v136, s38, v132
    global_load_dwordx4 v[132:135], v132, s[20:21] nt
    v_add_u32 v140, s38, v136
    global_load_dwordx4 v[136:139], v136, s[20:21] nt
    global_load_dwordx4 v[140:143], v140, s[20:21] nt
    s_mov_b64 exec, -1
    global_load_ushort v9, v9, s[22:23]
    v_add_u32 v148, s39, v144
    global_load_dwordx4 v[144:147], v144, s[24:25] nt
    v_add_u32 v152, s39, v148
    global_load_dwordx4 v[148:151], v148, s[24:25] nt
    v_add_u32 v156, s39, v152
    global_load_dwordx4 v[152:155], v152, s[24:25] nt
    v_add_u32 v160, s39, v156
    global_load_dwordx4 v[156:159], v156, s[24:25] nt
    v_add_u32 v164, s39, v160
    global_load_dwordx4 v[160:163], v160, s[24:25] nt
    s_cmp_eq_u32 s37, 5
    s_cselect_b64 exec, 1, -1
    s_cselect_b32 s39, s39, 0
    v_subrev_u32 v164, s39, v164
    global_load_dwordx4 v[164:167], v164, s[24:25] nt
    s_mov_b64 exec, -1
    s_lshl_b32 s7, s5, 5
    s_add_u32 s7, s7, s4
    s_lshl_b32 s7, s7, 9
    s_add_u32 s7, s7, 1048576
    v_lshl_add_u32 v15, v1, 7, s7
    s_mov_b64 exec, 0xf
    global_load_dword v15, v15, s[32:33]
    s_mov_b64 exec, -1
    s_barrier
    v_and_b32 v13, 1, v1
    v_lshlrev_b32 v13, 4, v13
    v_mov_b32 v14, 0xffff
    v_lshlrev_b32 v13, v13, v14
    v_bfe_u32 v14, v1, 1, 2
    v_cmp_eq_u32 s[44:45], 0, v14
    v_mov_b32 v192, 0
    v_cmp_eq_u32 s[46:47], 1, v14
    v_mov_b32 v193, 0
    v_cmp_eq_u32 s[48:49], 2, v14
    v_mov_b32 v194, 0
    v_cmp_eq_u32 s[50:51], 3, v14
    v_mov_b32 v195, 0
    v_mov_b32_dpp v192, v13 quad_perm:[0,1,2,3] row_mask:0xf bank_mask:0x1
    v_cndmask_b32 v196, 0, v13, s[44:45]
    v_mov_b32_dpp v193, v13 quad_perm:[0,1,2,3] row_mask:0xf bank_mask:0x2
    v_cndmask_b32 v197, 0, v13, s[46:47]
    v_mov_b32_dpp v194, v13 quad_perm:[0,1,2,3] row_mask:0xf bank_mask:0x4
    v_cndmask_b32 v198, 0, v13, s[48:49]
    v_mov_b32_dpp v195, v13 quad_perm:[0,1,2,3] row_mask:0xf bank_mask:0x8
    v_cndmask_b32 v199, 0, v13, s[50:51]
    s_lshl_b32 s7, s58, 13
    s_lshl_b32 s35, s59, 10
    s_add_u32 s35, s35, s7
    s_add_u32 s35, s35, 65536
    v_add_u32 v200, s35, v10
    s_lshl_b32 s7, s4, 6
    s_add_u32 s7, s7, 32768
    v_and_b32 v13, 7, v1
    v_lshl_add_u32 v206, v13, 3, s7
    s_lshl3_add_u32 s7, s5, s7
    v_mov_b32 v207, s7
    s_lshl_b32 s7, s4, 13
    s_add_u32 s7, s7, 69632
    v_add_u32 v201, s7, v10
    v_add_u32 v202, 0x50000, v201
    v_add_u32 v205, 0x50000, v200
    s_lshl_b32 s7, s5, 5
    s_add_u32 s7, s7, s4
    s_lshl_b32 s7, s7, 9
    s_add_u32 s7, s7, 1310720
    v_and_b32 v13, 1, v3
    v_lshlrev_b32 v13, 5, v13
    v_lshl_or_b32 v13, v2, 6, v13
    v_lshrrev_b32 v14, 1, v3
    v_lshl_or_b32 v13, v14, 3, v13
    v_add_u32 v204, s7, v13
    v_and_b32 v13, 3, v1
    v_lshlrev_b32 v13, 2, v13
    v_mov_b32 v14, 0
    ds_write_b32 v13, v14 offset:256
    s_mov_b32 s40, 100000
    s_getreg_b32 s39, hwreg(HW_REG_XCC_ID, 0, 4)
    s_waitcnt vmcnt(40)
    v_lshlrev_b32 v168, 16, v4
    v_and_b32 v169, 0xffff0000, v4
    v_lshlrev_b32 v170, 16, v5
    v_and_b32 v171, 0xffff0000, v5
    v_lshlrev_b32 v172, 16, v6
    v_and_b32 v173, 0xffff0000, v6
    v_lshlrev_b32 v174, 16, v7
    v_and_b32 v175, 0xffff0000, v7
    v_lshlrev_b32 v8, 16, v8
    v_add_f32 v4, v168, v169
    v_add_f32 v5, v170, v171
    v_add_f32 v4, v4, v172
    v_add_f32 v5, v5, v173
    v_add_f32 v4, v4, v174
    v_add_f32 v5, v5, v175
    v_add_f32 v4, v4, v5
    s_nop 1
    v_add_f32_dpp v4, v4, v4 row_ror:1 row_mask:0xf bank_mask:0xf
    s_nop 1
    v_add_f32_dpp v4, v4, v4 row_ror:2 row_mask:0xf bank_mask:0xf
    s_nop 1
    v_add_f32_dpp v4, v4, v4 row_ror:4 row_mask:0xf bank_mask:0xf
    s_nop 1
    v_add_f32_dpp v4, v4, v4 row_ror:8 row_mask:0xf bank_mask:0xf
    s_nop 1
    v_add_f32_dpp v4, v4, v4 row_bcast:15 row_mask:0xa bank_mask:0xf
    s_nop 1
    v_add_f32_dpp v4, v4, v4 row_bcast:31 row_mask:0xc bank_mask:0xf
    v_mul_f32 v4, 0x3b000000, v4
    s_nop 0
    v_readlane_b32 s35, v4, 63
    s_nop 1
    v_subrev_f32 v4, s35, v168
    v_subrev_f32 v6, s35, v169
    v_mul_f32 v4, v4, v4
    v_mul_f32 v5, v6, v6
    v_subrev_f32 v7, s35, v170
    v_subrev_f32 v6, s35, v171
    v_fmac_f32 v4, v7, v7
    v_fmac_f32 v5, v6, v6
    v_subrev_f32 v7, s35, v172
    v_subrev_f32 v6, s35, v173
    v_fmac_f32 v4, v7, v7
    v_fmac_f32 v5, v6, v6
    v_subrev_f32 v7, s35, v174
    v_subrev_f32 v6, s35, v175
    v_fmac_f32 v4, v7, v7
    v_fmac_f32 v5, v6, v6
    v_add_f32 v4, v4, v5
    v_mov_b32 v6, s35
    s_nop 1
    v_add_f32_dpp v4, v4, v4 row_ror:1 row_mask:0xf bank_mask:0xf
    s_nop 1
    v_add_f32_dpp v4, v4, v4 row_ror:2 row_mask:0xf bank_mask:0xf
    s_nop 1
    v_add_f32_dpp v4, v4, v4 row_ror:4 row_mask:0xf bank_mask:0xf
    s_nop 1
    v_add_f32_dpp v4, v4, v4 row_ror:8 row_mask:0xf bank_mask:0xf
    s_nop 1
    v_add_f32_dpp v4, v4, v4 row_bcast:15 row_mask:0xa bank_mask:0xf
    s_nop 1
    v_add_f32_dpp v4, v4, v4 row_bcast:31 row_mask:0xc bank_mask:0xf
    v_mul_f32 v4, 0x3b000000, v4
    v_cvt_pk_bf16_f32 v6, v6, v6
    v_and_b32 v6, 0xffff0000, v6
    v_readlane_b32 s35, v4, 63
    s_nop 1
    v_mov_b32 v4, s35
    v_cvt_pk_bf16_f32 v4, v4, v4
    v_and_b32 v4, 0xffff0000, v4
    v_add_f32 v4, 0x3727c5ac, v4
    v_cvt_pk_bf16_f32 v4, v4, v4
    v_and_b32 v4, 0xffff0000, v4
    v_sqrt_f32 v4, v4
    s_nop 0
    v_cvt_pk_bf16_f32 v4, v4, v4
    v_and_b32 v4, 0xffff0000, v4
    v_rcp_f32 v7, v4
    s_nop 0
    v_sub_f32 v8, v8, v6
    v_cvt_pk_bf16_f32 v8, v8, v8
    v_and_b32 v8, 0xffff0000, v8
    v_mul_f32 v8, v8, v7
    v_cvt_pk_bf16_f32 v8, v8, v8
    s_nop 1
    v_and_b32_dpp v176, v8, v192 row_newbcast:0 row_mask:0xf bank_mask:0xf
    v_and_b32_dpp v177, v8, v193 row_newbcast:0 row_mask:0xf bank_mask:0xf
    v_and_b32_dpp v178, v8, v194 row_newbcast:0 row_mask:0xf bank_mask:0xf
    v_and_b32_dpp v179, v8, v195 row_newbcast:0 row_mask:0xf bank_mask:0xf
    v_and_b32_dpp v180, v8, v192 row_newbcast:1 row_mask:0xf bank_mask:0xf
    v_and_b32_dpp v181, v8, v193 row_newbcast:1 row_mask:0xf bank_mask:0xf
    v_and_b32_dpp v182, v8, v194 row_newbcast:1 row_mask:0xf bank_mask:0xf
    v_and_b32_dpp v183, v8, v195 row_newbcast:1 row_mask:0xf bank_mask:0xf
    s_waitcnt vmcnt(36)
    v_mfma_f32_16x16x32_bf16 v[184:187], v[176:179], v[16:19], 0
    v_and_b32_dpp v176, v8, v192 row_newbcast:2 row_mask:0xf bank_mask:0xf
    v_and_b32_dpp v177, v8, v193 row_newbcast:2 row_mask:0xf bank_mask:0xf
    v_and_b32_dpp v178, v8, v194 row_newbcast:2 row_mask:0xf bank_mask:0xf
    v_and_b32_dpp v179, v8, v195 row_newbcast:2 row_mask:0xf bank_mask:0xf
    v_mfma_f32_16x16x32_bf16 v[184:187], v[180:183], v[20:23], v[184:187]
    v_and_b32_dpp v180, v8, v192 row_newbcast:3 row_mask:0xf bank_mask:0xf
    v_and_b32_dpp v181, v8, v193 row_newbcast:3 row_mask:0xf bank_mask:0xf
    v_and_b32_dpp v182, v8, v194 row_newbcast:3 row_mask:0xf bank_mask:0xf
    v_and_b32_dpp v183, v8, v195 row_newbcast:3 row_mask:0xf bank_mask:0xf
    v_mfma_f32_16x16x32_bf16 v[184:187], v[176:179], v[24:27], v[184:187]
    v_and_b32_dpp v176, v8, v192 row_newbcast:4 row_mask:0xf bank_mask:0xf
    v_and_b32_dpp v177, v8, v193 row_newbcast:4 row_mask:0xf bank_mask:0xf
    v_and_b32_dpp v178, v8, v194 row_newbcast:4 row_mask:0xf bank_mask:0xf
    v_and_b32_dpp v179, v8, v195 row_newbcast:4 row_mask:0xf bank_mask:0xf
    v_mfma_f32_16x16x32_bf16 v[184:187], v[180:183], v[28:31], v[184:187]
    v_and_b32_dpp v180, v8, v192 row_newbcast:5 row_mask:0xf bank_mask:0xf
    v_and_b32_dpp v181, v8, v193 row_newbcast:5 row_mask:0xf bank_mask:0xf
    v_and_b32_dpp v182, v8, v194 row_newbcast:5 row_mask:0xf bank_mask:0xf
    v_and_b32_dpp v183, v8, v195 row_newbcast:5 row_mask:0xf bank_mask:0xf
    s_waitcnt vmcnt(32)
    v_mfma_f32_16x16x32_bf16 v[184:187], v[176:179], v[32:35], v[184:187]
    v_and_b32_dpp v176, v8, v192 row_newbcast:6 row_mask:0xf bank_mask:0xf
    v_and_b32_dpp v177, v8, v193 row_newbcast:6 row_mask:0xf bank_mask:0xf
    v_and_b32_dpp v178, v8, v194 row_newbcast:6 row_mask:0xf bank_mask:0xf
    v_and_b32_dpp v179, v8, v195 row_newbcast:6 row_mask:0xf bank_mask:0xf
    v_mfma_f32_16x16x32_bf16 v[184:187], v[180:183], v[36:39], v[184:187]
    v_and_b32_dpp v180, v8, v192 row_newbcast:7 row_mask:0xf bank_mask:0xf
    v_and_b32_dpp v181, v8, v193 row_newbcast:7 row_mask:0xf bank_mask:0xf
    v_and_b32_dpp v182, v8, v194 row_newbcast:7 row_mask:0xf bank_mask:0xf
    v_and_b32_dpp v183, v8, v195 row_newbcast:7 row_mask:0xf bank_mask:0xf
    v_mfma_f32_16x16x32_bf16 v[184:187], v[176:179], v[40:43], v[184:187]
    v_and_b32_dpp v176, v8, v192 row_newbcast:8 row_mask:0xf bank_mask:0xf
    v_and_b32_dpp v177, v8, v193 row_newbcast:8 row_mask:0xf bank_mask:0xf
    v_and_b32_dpp v178, v8, v194 row_newbcast:8 row_mask:0xf bank_mask:0xf
    v_and_b32_dpp v179, v8, v195 row_newbcast:8 row_mask:0xf bank_mask:0xf
    v_mfma_f32_16x16x32_bf16 v[184:187], v[180:183], v[44:47], v[184:187]
    v_and_b32_dpp v180, v8, v192 row_newbcast:9 row_mask:0xf bank_mask:0xf
    v_and_b32_dpp v181, v8, v193 row_newbcast:9 row_mask:0xf bank_mask:0xf
    v_and_b32_dpp v182, v8, v194 row_newbcast:9 row_mask:0xf bank_mask:0xf
    v_and_b32_dpp v183, v8, v195 row_newbcast:9 row_mask:0xf bank_mask:0xf
    s_waitcnt vmcnt(28)
    v_mfma_f32_16x16x32_bf16 v[184:187], v[176:179], v[48:51], v[184:187]
    v_and_b32_dpp v176, v8, v192 row_newbcast:10 row_mask:0xf bank_mask:0xf
    v_and_b32_dpp v177, v8, v193 row_newbcast:10 row_mask:0xf bank_mask:0xf
    v_and_b32_dpp v178, v8, v194 row_newbcast:10 row_mask:0xf bank_mask:0xf
    v_and_b32_dpp v179, v8, v195 row_newbcast:10 row_mask:0xf bank_mask:0xf
    v_mfma_f32_16x16x32_bf16 v[184:187], v[180:183], v[52:55], v[184:187]
    v_and_b32_dpp v180, v8, v192 row_newbcast:11 row_mask:0xf bank_mask:0xf
    v_and_b32_dpp v181, v8, v193 row_newbcast:11 row_mask:0xf bank_mask:0xf
    v_and_b32_dpp v182, v8, v194 row_newbcast:11 row_mask:0xf bank_mask:0xf
    v_and_b32_dpp v183, v8, v195 row_newbcast:11 row_mask:0xf bank_mask:0xf
    v_mfma_f32_16x16x32_bf16 v[184:187], v[176:179], v[56:59], v[184:187]
    v_and_b32_dpp v176, v8, v192 row_newbcast:12 row_mask:0xf bank_mask:0xf
    v_and_b32_dpp v177, v8, v193 row_newbcast:12 row_mask:0xf bank_mask:0xf
    v_and_b32_dpp v178, v8, v194 row_newbcast:12 row_mask:0xf bank_mask:0xf
    v_and_b32_dpp v179, v8, v195 row_newbcast:12 row_mask:0xf bank_mask:0xf
    v_mfma_f32_16x16x32_bf16 v[184:187], v[180:183], v[60:63], v[184:187]
    v_and_b32_dpp v180, v8, v192 row_newbcast:13 row_mask:0xf bank_mask:0xf
    v_and_b32_dpp v181, v8, v193 row_newbcast:13 row_mask:0xf bank_mask:0xf
    v_and_b32_dpp v182, v8, v194 row_newbcast:13 row_mask:0xf bank_mask:0xf
    v_and_b32_dpp v183, v8, v195 row_newbcast:13 row_mask:0xf bank_mask:0xf
    s_waitcnt vmcnt(27)
    v_mfma_f32_16x16x32_bf16 v[184:187], v[176:179], v[64:67], v[184:187]
    v_and_b32_dpp v176, v8, v192 row_newbcast:14 row_mask:0xf bank_mask:0xf
    v_and_b32_dpp v177, v8, v193 row_newbcast:14 row_mask:0xf bank_mask:0xf
    v_and_b32_dpp v178, v8, v194 row_newbcast:14 row_mask:0xf bank_mask:0xf
    v_and_b32_dpp v179, v8, v195 row_newbcast:14 row_mask:0xf bank_mask:0xf
    s_waitcnt vmcnt(26)
    v_mfma_f32_16x16x32_bf16 v[184:187], v[180:183], v[68:71], v[184:187]
    v_and_b32_dpp v180, v8, v192 row_newbcast:15 row_mask:0xf bank_mask:0xf
    v_and_b32_dpp v181, v8, v193 row_newbcast:15 row_mask:0xf bank_mask:0xf
    v_and_b32_dpp v182, v8, v194 row_newbcast:15 row_mask:0xf bank_mask:0xf
    v_and_b32_dpp v183, v8, v195 row_newbcast:15 row_mask:0xf bank_mask:0xf
    s_waitcnt vmcnt(25)
    v_mfma_f32_16x16x32_bf16 v[184:187], v[176:179], v[72:75], v[184:187]
    s_nop 1
    s_waitcnt vmcnt(24)
    v_mfma_f32_16x16x32_bf16 v[184:187], v[180:183], v[76:79], v[184:187]
    v_sub_f32 v168, v168, v6
    v_sub_f32 v169, v169, v6
    v_sub_f32 v170, v170, v6
    v_sub_f32 v171, v171, v6
    v_sub_f32 v172, v172, v6
    v_sub_f32 v173, v173, v6
    v_sub_f32 v174, v174, v6
    v_sub_f32 v175, v175, v6
    v_cvt_pk_bf16_f32 v168, v168, v168
    v_and_b32 v168, 0xffff0000, v168
    v_cvt_pk_bf16_f32 v169, v169, v169
    v_and_b32 v169, 0xffff0000, v169
    v_cvt_pk_bf16_f32 v170, v170, v170
    v_and_b32 v170, 0xffff0000, v170
    v_cvt_pk_bf16_f32 v171, v171, v171
    v_and_b32 v171, 0xffff0000, v171
    v_cvt_pk_bf16_f32 v172, v172, v172
    v_and_b32 v172, 0xffff0000, v172
    v_cvt_pk_bf16_f32 v173, v173, v173
    v_and_b32 v173, 0xffff0000, v173
    v_cvt_pk_bf16_f32 v174, v174, v174
    v_and_b32 v174, 0xffff0000, v174
    v_cvt_pk_bf16_f32 v175, v175, v175
    v_and_b32 v175, 0xffff0000, v175
    v_mul_f32 v168, v168, v7
    v_mul_f32 v169, v169, v7
    v_mul_f32 v170, v170, v7
    v_mul_f32 v171, v171, v7
    v_mul_f32 v172, v172, v7
    v_mul_f32 v173, v173, v7
    v_mul_f32 v174, v174, v7
    v_mul_f32 v175, v175, v7
    v_cvt_pk_bf16_f32 v168, v168, v168
    v_and_b32 v168, 0xffff0000, v168
    v_cvt_pk_bf16_f32 v169, v169, v169
    v_and_b32 v169, 0xffff0000, v169
    v_cvt_pk_bf16_f32 v170, v170, v170
    v_and_b32 v170, 0xffff0000, v170
    v_cvt_pk_bf16_f32 v171, v171, v171
    v_and_b32 v171, 0xffff0000, v171
    v_cvt_pk_bf16_f32 v172, v172, v172
    v_and_b32 v172, 0xffff0000, v172
    v_cvt_pk_bf16_f32 v173, v173, v173
    v_and_b32 v173, 0xffff0000, v173
    v_cvt_pk_bf16_f32 v174, v174, v174
    v_and_b32 v174, 0xffff0000, v174
    v_cvt_pk_bf16_f32 v175, v175, v175
    v_and_b32 v175, 0xffff0000, v175
    v_and_b32 v8, 0xffff0000, v8
    v_add_f32 v4, v168, v169
    v_add_f32 v5, v170, v171
    v_add_f32 v4, v4, v172
    v_add_f32 v5, v5, v173
    v_add_f32 v4, v4, v174
    v_add_f32 v5, v5, v175
    v_add_f32 v4, v4, v5
    s_nop 1
    v_add_f32_dpp v4, v4, v4 row_ror:1 row_mask:0xf bank_mask:0xf
    s_nop 1
    v_add_f32_dpp v4, v4, v4 row_ror:2 row_mask:0xf bank_mask:0xf
    s_nop 1
    v_add_f32_dpp v4, v4, v4 row_ror:4 row_mask:0xf bank_mask:0xf
    s_nop 1
    v_add_f32_dpp v4, v4, v4 row_ror:8 row_mask:0xf bank_mask:0xf
    s_nop 1
    v_add_f32_dpp v4, v4, v4 row_bcast:15 row_mask:0xa bank_mask:0xf
    s_nop 1
    v_add_f32_dpp v4, v4, v4 row_bcast:31 row_mask:0xc bank_mask:0xf
    v_mul_f32 v4, 0x3b000000, v4
    s_nop 0
    v_readlane_b32 s35, v4, 63
    s_nop 1
    v_subrev_f32 v4, s35, v168
    v_subrev_f32 v6, s35, v169
    v_mul_f32 v4, v4, v4
    v_mul_f32 v5, v6, v6
    v_subrev_f32 v7, s35, v170
    v_subrev_f32 v6, s35, v171
    v_fmac_f32 v4, v7, v7
    v_fmac_f32 v5, v6, v6
    v_subrev_f32 v7, s35, v172
    v_subrev_f32 v6, s35, v173
    v_fmac_f32 v4, v7, v7
    v_fmac_f32 v5, v6, v6
    v_subrev_f32 v7, s35, v174
    v_subrev_f32 v6, s35, v175
    v_fmac_f32 v4, v7, v7
    v_fmac_f32 v5, v6, v6
    v_add_f32 v4, v4, v5
    v_mov_b32 v6, s35
    s_nop 1
    v_add_f32_dpp v4, v4, v4 row_ror:1 row_mask:0xf bank_mask:0xf
    s_nop 1
    v_add_f32_dpp v4, v4, v4 row_ror:2 row_mask:0xf bank_mask:0xf
    s_nop 1
    v_add_f32_dpp v4, v4, v4 row_ror:4 row_mask:0xf bank_mask:0xf
    s_nop 1
    v_add_f32_dpp v4, v4, v4 row_ror:8 row_mask:0xf bank_mask:0xf
    s_nop 1
    v_add_f32_dpp v4, v4, v4 row_bcast:15 row_mask:0xa bank_mask:0xf
    s_nop 1
    v_add_f32_dpp v4, v4, v4 row_bcast:31 row_mask:0xc bank_mask:0xf
    v_mul_f32 v4, 0x3b000000, v4
    v_cvt_pk_bf16_f32 v6, v6, v6
    v_and_b32 v6, 0xffff0000, v6
    v_readlane_b32 s35, v4, 63
    s_nop 1
    v_mov_b32 v4, s35
    v_cvt_pk_bf16_f32 v4, v4, v4
    v_and_b32 v4, 0xffff0000, v4
    v_add_f32 v4, 0x3727c5ac, v4
    v_cvt_pk_bf16_f32 v4, v4, v4
    v_and_b32 v4, 0xffff0000, v4
    v_sqrt_f32 v4, v4
    s_nop 0
    v_cvt_pk_bf16_f32 v4, v4, v4
    v_and_b32 v4, 0xffff0000, v4
    v_rcp_f32 v7, v4
    s_nop 0
    v_sub_f32 v8, v8, v6
    v_cvt_pk_bf16_f32 v8, v8, v8
    v_and_b32 v8, 0xffff0000, v8
    v_mul_f32 v8, v8, v7
    v_cvt_pk_bf16_f32 v8, v8, v8
    s_nop 1
    v_and_b32_dpp v176, v8, v192 row_newbcast:0 row_mask:0xf bank_mask:0xf
    v_and_b32_dpp v177, v8, v193 row_newbcast:0 row_mask:0xf bank_mask:0xf
    v_and_b32_dpp v178, v8, v194 row_newbcast:0 row_mask:0xf bank_mask:0xf
    v_and_b32_dpp v179, v8, v195 row_newbcast:0 row_mask:0xf bank_mask:0xf
    v_and_b32_dpp v180, v8, v192 row_newbcast:1 row_mask:0xf bank_mask:0xf
    v_and_b32_dpp v181, v8, v193 row_newbcast:1 row_mask:0xf bank_mask:0xf
    v_and_b32_dpp v182, v8, v194 row_newbcast:1 row_mask:0xf bank_mask:0xf
    v_and_b32_dpp v183, v8, v195 row_newbcast:1 row_mask:0xf bank_mask:0xf
    s_waitcnt vmcnt(20)
    v_mfma_f32_16x16x32_bf16 v[188:191], v[176:179], v[80:83], 0
    v_and_b32_dpp v176, v8, v192 row_newbcast:2 row_mask:0xf bank_mask:0xf
    v_and_b32_dpp v177, v8, v193 row_newbcast:2 row_mask:0xf bank_mask:0xf
    v_and_b32_dpp v178, v8, v194 row_newbcast:2 row_mask:0xf bank_mask:0xf
    v_and_b32_dpp v179, v8, v195 row_newbcast:2 row_mask:0xf bank_mask:0xf
    v_mfma_f32_16x16x32_bf16 v[188:191], v[180:183], v[84:87], v[188:191]
    v_and_b32_dpp v180, v8, v192 row_newbcast:3 row_mask:0xf bank_mask:0xf
    v_and_b32_dpp v181, v8, v193 row_newbcast:3 row_mask:0xf bank_mask:0xf
    v_and_b32_dpp v182, v8, v194 row_newbcast:3 row_mask:0xf bank_mask:0xf
    v_and_b32_dpp v183, v8, v195 row_newbcast:3 row_mask:0xf bank_mask:0xf
    v_mfma_f32_16x16x32_bf16 v[188:191], v[176:179], v[88:91], v[188:191]
    v_and_b32_dpp v176, v8, v192 row_newbcast:4 row_mask:0xf bank_mask:0xf
    v_and_b32_dpp v177, v8, v193 row_newbcast:4 row_mask:0xf bank_mask:0xf
    v_and_b32_dpp v178, v8, v194 row_newbcast:4 row_mask:0xf bank_mask:0xf
    v_and_b32_dpp v179, v8, v195 row_newbcast:4 row_mask:0xf bank_mask:0xf
    v_mfma_f32_16x16x32_bf16 v[188:191], v[180:183], v[92:95], v[188:191]
    v_and_b32_dpp v180, v8, v192 row_newbcast:5 row_mask:0xf bank_mask:0xf
    v_and_b32_dpp v181, v8, v193 row_newbcast:5 row_mask:0xf bank_mask:0xf
    v_and_b32_dpp v182, v8, v194 row_newbcast:5 row_mask:0xf bank_mask:0xf
    v_and_b32_dpp v183, v8, v195 row_newbcast:5 row_mask:0xf bank_mask:0xf
    s_waitcnt vmcnt(16)
    v_mfma_f32_16x16x32_bf16 v[188:191], v[176:179], v[96:99], v[188:191]
    v_and_b32_dpp v176, v8, v192 row_newbcast:6 row_mask:0xf bank_mask:0xf
    v_and_b32_dpp v177, v8, v193 row_newbcast:6 row_mask:0xf bank_mask:0xf
    v_and_b32_dpp v178, v8, v194 row_newbcast:6 row_mask:0xf bank_mask:0xf
    v_and_b32_dpp v179, v8, v195 row_newbcast:6 row_mask:0xf bank_mask:0xf
    v_mfma_f32_16x16x32_bf16 v[188:191], v[180:183], v[100:103], v[188:191]
    v_and_b32_dpp v180, v8, v192 row_newbcast:7 row_mask:0xf bank_mask:0xf
    v_and_b32_dpp v181, v8, v193 row_newbcast:7 row_mask:0xf bank_mask:0xf
    v_and_b32_dpp v182, v8, v194 row_newbcast:7 row_mask:0xf bank_mask:0xf
    v_and_b32_dpp v183, v8, v195 row_newbcast:7 row_mask:0xf bank_mask:0xf
    v_mfma_f32_16x16x32_bf16 v[188:191], v[176:179], v[104:107], v[188:191]
    v_and_b32_dpp v176, v8, v192 row_newbcast:8 row_mask:0xf bank_mask:0xf
    v_and_b32_dpp v177, v8, v193 row_newbcast:8 row_mask:0xf bank_mask:0xf
    v_and_b32_dpp v178, v8, v194 row_newbcast:8 row_mask:0xf bank_mask:0xf
    v_and_b32_dpp v179, v8, v195 row_newbcast:8 row_mask:0xf bank_mask:0xf
    v_mfma_f32_16x16x32_bf16 v[188:191], v[180:183], v[108:111], v[188:191]
    v_and_b32_dpp v180, v8, v192 row_newbcast:9 row_mask:0xf bank_mask:0xf
    v_and_b32_dpp v181, v8, v193 row_newbcast:9 row_mask:0xf bank_mask:0xf
    v_and_b32_dpp v182, v8, v194 row_newbcast:9 row_mask:0xf bank_mask:0xf
    v_and_b32_dpp v183, v8, v195 row_newbcast:9 row_mask:0xf bank_mask:0xf
    s_waitcnt vmcnt(12)
    v_mfma_f32_16x16x32_bf16 v[188:191], v[176:179], v[112:115], v[188:191]
    v_and_b32_dpp v176, v8, v192 row_newbcast:10 row_mask:0xf bank_mask:0xf
    v_and_b32_dpp v177, v8, v193 row_newbcast:10 row_mask:0xf bank_mask:0xf
    v_and_b32_dpp v178, v8, v194 row_newbcast:10 row_mask:0xf bank_mask:0xf
    v_and_b32_dpp v179, v8, v195 row_newbcast:10 row_mask:0xf bank_mask:0xf
    v_mfma_f32_16x16x32_bf16 v[188:191], v[180:183], v[116:119], v[188:191]
    v_and_b32_dpp v180, v8, v192 row_newbcast:11 row_mask:0xf bank_mask:0xf
    v_and_b32_dpp v181, v8, v193 row_newbcast:11 row_mask:0xf bank_mask:0xf
    v_and_b32_dpp v182, v8, v194 row_newbcast:11 row_mask:0xf bank_mask:0xf
    v_and_b32_dpp v183, v8, v195 row_newbcast:11 row_mask:0xf bank_mask:0xf
    v_mfma_f32_16x16x32_bf16 v[188:191], v[176:179], v[120:123], v[188:191]
    v_and_b32_dpp v176, v8, v192 row_newbcast:12 row_mask:0xf bank_mask:0xf
    v_and_b32_dpp v177, v8, v193 row_newbcast:12 row_mask:0xf bank_mask:0xf
    v_and_b32_dpp v178, v8, v194 row_newbcast:12 row_mask:0xf bank_mask:0xf
    v_and_b32_dpp v179, v8, v195 row_newbcast:12 row_mask:0xf bank_mask:0xf
    v_mfma_f32_16x16x32_bf16 v[188:191], v[180:183], v[124:127], v[188:191]
    v_and_b32_dpp v180, v8, v192 row_newbcast:13 row_mask:0xf bank_mask:0xf
    v_and_b32_dpp v181, v8, v193 row_newbcast:13 row_mask:0xf bank_mask:0xf
    v_and_b32_dpp v182, v8, v194 row_newbcast:13 row_mask:0xf bank_mask:0xf
    v_and_b32_dpp v183, v8, v195 row_newbcast:13 row_mask:0xf bank_mask:0xf
    s_waitcnt vmcnt(11)
    v_mfma_f32_16x16x32_bf16 v[188:191], v[176:179], v[128:131], v[188:191]
    v_and_b32_dpp v176, v8, v192 row_newbcast:14 row_mask:0xf bank_mask:0xf
    v_and_b32_dpp v177, v8, v193 row_newbcast:14 row_mask:0xf bank_mask:0xf
    v_and_b32_dpp v178, v8, v194 row_newbcast:14 row_mask:0xf bank_mask:0xf
    v_and_b32_dpp v179, v8, v195 row_newbcast:14 row_mask:0xf bank_mask:0xf
    s_waitcnt vmcnt(10)
    v_mfma_f32_16x16x32_bf16 v[188:191], v[180:183], v[132:135], v[188:191]
    v_and_b32_dpp v180, v8, v192 row_newbcast:15 row_mask:0xf bank_mask:0xf
    v_and_b32_dpp v181, v8, v193 row_newbcast:15 row_mask:0xf bank_mask:0xf
    v_and_b32_dpp v182, v8, v194 row_newbcast:15 row_mask:0xf bank_mask:0xf
    v_and_b32_dpp v183, v8, v195 row_newbcast:15 row_mask:0xf bank_mask:0xf
    s_waitcnt vmcnt(9)
    v_mfma_f32_16x16x32_bf16 v[188:191], v[176:179], v[136:139], v[188:191]
    s_nop 1
    s_waitcnt vmcnt(8)
    v_mfma_f32_16x16x32_bf16 v[188:191], v[180:183], v[140:143], v[188:191]
    s_waitcnt lgkmcnt(0)
    s_add_u32 s34, s34, 0x01010101
    v_mov_b32 v187, s39
    v_mov_b32 v186, s34
    s_mov_b32 s56, 0x3f3f3f3f
    s_mov_b32 s57, s56
    s_nop 1
    v_mov_b32_dpp v188, v189 row_ror:8 row_mask:0xf bank_mask:0xc
    v_cndmask_b32 v187, v187, v188, s[56:57]
    global_store_dwordx4 v200, v[184:187], s[32:33] sc1
    v_mov_b32 v12, s39
    v_mov_b32 v13, s34
    s_mov_b64 exec, 1
    global_store_dwordx2 v207, v[12:13], s[32:33] sc1
    s_mov_b64 exec, -1
    s_barrier
L_pollq:
    global_load_dwordx4 v[16:19], v201, s[32:33] offset:-4096 sc1
    global_load_dwordx4 v[20:23], v201, s[32:33] offset:-3072 sc1
    global_load_dwordx4 v[24:27], v201, s[32:33] offset:-2048 sc1
    global_load_dwordx4 v[28:31], v201, s[32:33] offset:-1024 sc1
    global_load_dwordx4 v[32:35], v201, s[32:33] offset:0 sc1
    global_load_dwordx4 v[36:39], v201, s[32:33] offset:1024 sc1
    global_load_dwordx4 v[40:43], v201, s[32:33] offset:2048 sc1
    global_load_dwordx4 v[44:47], v201, s[32:33] offset:3072 sc1
    global_load_dwordx2 v[48:49], v206, s[32:33] sc1
    s_sub_u32 s40, s40, 1
    s_cbranch_scc1 L_end
    s_waitcnt vmcnt(0)
L_warm3:
    v_bitop3_b32 v10, v18, v22, s34 bitop3:0x7e
    v_bitop3_b32 v11, v26, v30, s34 bitop3:0x7e
    v_bitop3_b32 v12, v34, v38, s34 bitop3:0x7e
    v_bitop3_b32 v13, v42, v46, s34 bitop3:0x7e
    v_or3_b32 v10, v10, v11, v12
    v_or_b32 v10, v10, v13
    v_xor_b32 v11, s34, v49
    v_or_b32 v10, v10, v11
    v_cmp_ne_u32 vcc, 0, v10
    s_cbranch_vccnz L_pollq
    v_pk_add_f32 v[16:17], v[16:17], v[20:21]
    v_pk_add_f32 v[24:25], v[24:25], v[28:29]
    v_pk_add_f32 v[32:33], v[32:33], v[36:37]
    v_pk_add_f32 v[40:41], v[40:41], v[44:45]
    v_pk_add_f32 v[16:17], v[16:17], v[24:25]
    v_pk_add_f32 v[32:33], v[32:33], v[40:41]
    v_pk_add_f32 v[16:17], v[16:17], v[32:33]
    v_cvt_pk_bf16_f32 v16, v16, v17
    ds_write_b32 v203, v16 offset:0
    v_cmp_ne_u32 vcc, s39, v48
    s_cmp_lg_u64 vcc, 0
    s_cselect_b32 s35, 1, 0
    v_mov_b32 v10, s35
    v_mov_b32 v11, 0
    ds_write_b32 v11, v10 offset:304
    s_cbranch_execz L_chkz
    s_waitcnt lgkmcnt(0)
    s_barrier
    s_barrier
L_chkz:
    v_add_f32 v19, v19, v23
    v_add_f32 v27, v27, v31
    v_add_f32 v35, v35, v39
    v_add_f32 v43, v43, v47
    v_add_f32 v19, v19, v27
    v_add_f32 v35, v35, v43
    v_add_f32 v19, v19, v35
    v_cvt_pk_bf16_f32 v19, v19, v19
    v_and_b32 v19, 0xffff0000, v19
    v_lshlrev_b32 v9, 16, v9
    v_add_f32 v19, v19, v9
    v_cvt_pk_bf16_f32 v19, v19, v19
    v_and_b32 v19, 0xffff0000, v19
    v_mul_f32 v10, v19, v19
    v_mul_f32 v10, v10, v19
    v_fmamk_f32 v10, v10, 0x3d372713, v19
    v_mul_f32 v10, 0xc0135761, v10
    v_exp_f32 v10, v10
    s_nop 0
    v_add_f32 v10, 1.0, v10
    v_rcp_f32 v10, v10
    s_nop 0
    v_mul_f32 v10, v10, v19
    v_cvt_pk_bf16_f32 v10, v10, v10
    s_nop 1
    v_mov_b32_dpp v12, v10 row_newbcast:0 row_mask:0xf bank_mask:0x3
    v_mov_b32_dpp v12, v10 row_newbcast:8 row_mask:0xf bank_mask:0xc
    v_and_b32 v176, v12, v196
    v_and_b32 v177, v12, v197
    v_and_b32 v178, v12, v198
    v_and_b32 v179, v12, v199
    s_nop 1
    v_mfma_f32_16x16x32_bf16 v[184:187], v[176:179], v[144:147], 0
    v_mov_b32_dpp v12, v10 row_newbcast:1 row_mask:0xf bank_mask:0x3
    v_mov_b32_dpp v12, v10 row_newbcast:9 row_mask:0xf bank_mask:0xc
    v_and_b32 v180, v12, v196
    v_and_b32 v181, v12, v197
    v_and_b32 v182, v12, v198
    v_and_b32 v183, v12, v199
    s_nop 1
    v_mfma_f32_16x16x32_bf16 v[184:187], v[180:183], v[148:151], v[184:187]
    v_mov_b32_dpp v12, v10 row_newbcast:2 row_mask:0xf bank_mask:0x3
    v_mov_b32_dpp v12, v10 row_newbcast:10 row_mask:0xf bank_mask:0xc
    v_and_b32 v176, v12, v196
    v_and_b32 v177, v12, v197
    v_and_b32 v178, v12, v198
    v_and_b32 v179, v12, v199
    s_nop 1
    v_mfma_f32_16x16x32_bf16 v[184:187], v[176:179], v[152:155], v[184:187]
    v_mov_b32_dpp v12, v10 row_newbcast:3 row_mask:0xf bank_mask:0x3
    v_mov_b32_dpp v12, v10 row_newbcast:11 row_mask:0xf bank_mask:0xc
    v_and_b32 v180, v12, v196
    v_and_b32 v181, v12, v197
    v_and_b32 v182, v12, v198
    v_and_b32 v183, v12, v199
    s_nop 1
    v_mfma_f32_16x16x32_bf16 v[184:187], v[180:183], v[156:159], v[184:187]
    v_mov_b32_dpp v12, v10 row_newbcast:4 row_mask:0xf bank_mask:0x3
    v_mov_b32_dpp v12, v10 row_newbcast:12 row_mask:0xf bank_mask:0xc
    v_and_b32 v176, v12, v196
    v_and_b32 v177, v12, v197
    v_and_b32 v178, v12, v198
    v_and_b32 v179, v12, v199
    s_nop 1
    v_mfma_f32_16x16x32_bf16 v[184:187], v[176:179], v[160:163], v[184:187]
    s_cmp_eq_u32 s37, 5
    s_cbranch_scc1 L_five
    v_mov_b32_dpp v12, v10 row_newbcast:5 row_mask:0xf bank_mask:0x3
    v_mov_b32_dpp v12, v10 row_newbcast:13 row_mask:0xf bank_mask:0xc
    v_and_b32 v180, v12, v196
    v_and_b32 v181, v12, v197
    v_and_b32 v182, v12, v198
    v_and_b32 v183, v12, v199
    s_nop 1
    v_mfma_f32_16x16x32_bf16 v[184:187], v[180:183], v[164:167], v[184:187]
L_five:
    s_nop 7
    v_permlane32_swap_b32 v184, v185
    v_permlane32_swap_b32 v186, v187
    v_mov_b32 v11, s34
    v_mov_b32 v13, s34
    v_add_f32_dpp v10, v185, v184 row_ror:8 row_mask:0xf bank_mask:0xf
    v_add_f32_dpp v12, v187, v186 row_ror:8 row_mask:0xf bank_mask:0xf
    s_cbranch_execz L_wend
    s_mov_b32 exec_lo, 0x00ff00ff
    s_mov_b32 exec_hi, 0x00ff00ff
    global_store_dwordx2 v204, v[10:11], s[32:33] sc1
    global_store_dwordx2 v204, v[12:13], s[32:33] offset:16 sc1
    s_barrier
    s_barrier
    s_barrier
    s_endpgm
L_wend:
    s_endpgm
L_stream:
    s_lshl_b32 s7, s4, 21
    s_lshl_b32 s35, s5, 16
    s_add_u32 s7, s7, s35
    s_lshl_b32 s35, s3, 6
    s_add_u32 s7, s7, s35
    s_add_u32 s7, s7, 0x17f000
    s_and_b32 s35, s5, 1
    s_lshl_b32 s35, s35, 14
    s_add_u32 s7, s7, s35
    v_lshlrev_b32 v2, 4, v1
    v_and_b32 v3, 0x30, v2
    v_and_b32 v4, 0xc0, v2
    v_lshl_or_b32 v3, v4, 2, v3
    v_lshrrev_b32 v4, 4, v1
    v_lshl_or_b32 v3, v4, 6, v3
    v_add_u32 v28, s7, v3
    v_add_u32 v92, s7, v2
    v_xor_b32 v44, 0x4000, v28
    v_xor_b32 v60, 0x8000, v28
    v_xor_b32 v76, 0xc000, v28
    v_xor_b32 v108, 0x4000, v92
    v_xor_b32 v124, 0x8000, v92
    v_xor_b32 v140, 0xc000, v92
    s_lshr_b32 s6, s3, 6
    s_sub_u32 s6, s6, 1
    s_and_b32 s35, s4, 3
    s_lshl_b32 s35, s35, 5
    s_lshl_b32 s37, s5, 7
    s_add_u32 s35, s35, s37
    v_and_b32 v5, 7, v1
    v_and_b32 v6, 1, v4
    v_lshlrev_b32 v6, 1, v6
    v_lshl_or_b32 v6, v5, 2, v6
    v_add_u32 v204, s35, v6
    v_lshrrev_b32 v9, 3, v1
    s_lshl_b32 s35, s5, 14
    s_and_b32 s38, s4, 3
    s_lshl_b32 s38, s38, 7
    s_add_u32 s35, s35, s38
    s_add_u32 s35, s35, 1314816
    v_lshlrev_b32 v8, 9, v9
    v_lshl_or_b32 v8, v5, 4, v8
    v_add_u32 v211, s35, v8
    v_add_u32 v212, 0x2000, v211
    v_add_u32 v218, 0xfffc0000, v211
    v_add_u32 v219, 0x2000, v218
    s_lshr_b32 s35, s4, 2
    s_cmp_eq_u32 s35, s5
    s_cselect_b32 s53, s6, 0
    s_cmp_eq_u32 s53, 1
    s_waitcnt lgkmcnt(0)
    s_load_dword s34, s[32:33], 0
    s_cbranch_scc0 L_nosmall
    global_load_ushort v214, v204, s[8:9]
    global_load_ushort v215, v204, s[26:27]
    global_load_ushort v216, v204, s[28:29]
L_nosmall:
    s_barrier
    global_load_dwordx4 v[16:19], v28, s[10:11] offset:0 nt
    v_and_b32 v7, 1, v1
    global_load_dwordx4 v[20:23], v28, s[10:11] offset:1024 nt
    v_lshlrev_b32 v7, 4, v7
    global_load_dwordx4 v[24:27], v28, s[10:11] offset:2048 nt
    v_mov_b32 v6, 0xffff
    global_load_dwordx4 v[28:31], v28, s[10:11] offset:3072 nt
    v_lshlrev_b32 v7, v7, v6
    global_load_dwordx4 v[32:35], v44, s[10:11] offset:0 nt
    v_bfe_u32 v6, v1, 1, 2
    v_cmp_eq_u32 s[44:45], 0, v6
    v_mov_b32 v192, 0
    v_cmp_eq_u32 s[46:47], 1, v6
    v_mov_b32 v193, 0
    v_cmp_eq_u32 s[48:49], 2, v6
    v_mov_b32 v194, 0
    v_cmp_eq_u32 s[50:51], 3, v6
    v_mov_b32 v195, 0
    v_mov_b32_dpp v192, v7 quad_perm:[0,1,2,3] row_mask:0xf bank_mask:0x1
    v_cndmask_b32 v196, 0, v7, s[44:45]
    v_mov_b32_dpp v193, v7 quad_perm:[0,1,2,3] row_mask:0xf bank_mask:0x2
    v_cndmask_b32 v197, 0, v7, s[46:47]
    v_mov_b32_dpp v194, v7 quad_perm:[0,1,2,3] row_mask:0xf bank_mask:0x4
    v_cndmask_b32 v198, 0, v7, s[48:49]
    v_mov_b32_dpp v195, v7 quad_perm:[0,1,2,3] row_mask:0xf bank_mask:0x8
    v_cndmask_b32 v199, 0, v7, s[50:51]
    v_and_b32 v7, 0x30, v2
    v_lshl_or_b32 v7, v4, 6, v7
    v_mov_b32 v200, 256
    v_mov_b32 v201, 256
    v_mov_b32 v202, 256
    v_mov_b32 v203, 256
    v_mov_b32_dpp v200, v7 quad_perm:[0,1,2,3] row_mask:0xf bank_mask:0x1
    v_mov_b32_dpp v201, v7 quad_perm:[0,1,2,3] row_mask:0xf bank_mask:0x2
    v_mov_b32_dpp v202, v7 quad_perm:[0,1,2,3] row_mask:0xf bank_mask:0x4
    v_mov_b32_dpp v203, v7 quad_perm:[0,1,2,3] row_mask:0xf bank_mask:0x8
    s_lshl_b32 s36, s4, 3
    s_add_u32 s36, s36, s5
    s_lshl_b32 s36, s36, 10
    s_lshl_b32 s35, s4, 17
    s_add_u32 s35, s35, s37
    s_lshl_b32 s38, s6, 15
    s_add_u32 s35, s35, s38
    v_bfe_u32 v6, v1, 3, 1
    v_lshlrev_b32 v7, 13, v4
    v_lshl_or_b32 v7, v6, 12, v7
    v_lshl_or_b32 v7, v5, 4, v7
    v_add_u32 v156, s35, v7
    s_lshl_b32 s35, s4, 13
    s_add_u32 s35, s35, 720896
    s_lshl_b32 s38, s6, 11
    s_add_u32 s38, s38, s35
    v_lshlrev_b32 v7, 4, v5
    v_lshl_or_b32 v7, v4, 9, v7
    v_lshl_or_b32 v7, v6, 8, v7
    v_add_u32 v205, s38, v7
    v_and_b32 v7, 15, v1
    v_lshlrev_b32 v8, 9, v7
    v_lshl_or_b32 v8, v4, 7, v8
    s_lshl4_add_u32 s35, s5, s35
    v_add_u32 v206, s35, v8
    s_lshl_b32 s35, s6, 9
    s_add_u32 s35, s35, 512
    v_lshl_add_u32 v207, v1, 3, s35
    s_mul_i32 s35, s6, 1280
    s_add_u32 s35, s35, 2560
    v_mul_u32_u24 v8, 320, v4
    v_lshl_add_u32 v8, v7, 4, v8
    v_add_u32 v208, s35, v8
    v_bfe_u32 v8, v1, 2, 1
    v_mul_u32_u24 v8, 320, v8
    v_lshrrev_b32 v9, 3, v1
    v_lshl_add_u32 v8, v9, 4, v8
    v_and_b32 v10, 3, v1
    v_lshl_add_u32 v8, v10, 2, v8
    v_add_u32 v209, 2560, v8
    s_lshl_b32 s35, s5, 5
    s_add_u32 s35, s35, s4
    s_lshl_b32 s35, s35, 9
    s_add_u32 s35, s35, 1048576
    v_lshl_add_u32 v210, v1, 3, s35
    s_lshl_b32 s39, s6, 2
    v_mov_b32 v213, s39
    v_and_b32 v8, 1, v4
    v_cmp_eq_u32 s[42:43], 1, v8
    s_mov_b32 s40, 100000
    s_waitcnt lgkmcnt(0)
    s_add_u32 s34, s34, 0x01010101
    s_waitcnt vmcnt(4)
    global_load_dwordx4 v[36:39], v44, s[10:11] offset:1024 nt
    s_waitcnt vmcnt(4)
    global_load_dwordx4 v[40:43], v44, s[10:11] offset:2048 nt
    s_waitcnt vmcnt(4)
    global_load_dwordx4 v[44:47], v44, s[10:11] offset:3072 nt
    s_waitcnt vmcnt(4)
    global_load_dwordx4 v[48:51], v60, s[10:11] offset:0 nt
    s_waitcnt vmcnt(4)
    global_load_dwordx4 v[52:55], v60, s[10:11] offset:1024 nt
    s_waitcnt vmcnt(4)
    global_load_dwordx4 v[56:59], v60, s[10:11] offset:2048 nt
    s_waitcnt vmcnt(4)
    global_load_dwordx4 v[60:63], v60, s[10:11] offset:3072 nt
    s_waitcnt vmcnt(4)
    global_load_dwordx4 v[64:67], v76, s[10:11] offset:0 nt
    s_waitcnt vmcnt(4)
    global_load_dwordx4 v[68:71], v76, s[10:11] offset:1024 nt
    s_waitcnt vmcnt(4)
    global_load_dwordx4 v[72:75], v76, s[10:11] offset:2048 nt
    s_waitcnt vmcnt(4)
    global_load_dwordx4 v[76:79], v76, s[10:11] offset:3072 nt
    s_barrier
    s_waitcnt vmcnt(11)
    global_load_dwordx4 v[80:83], v92, s[12:13] offset:0 nt
    s_waitcnt vmcnt(11)
    global_load_dwordx4 v[84:87], v92, s[12:13] offset:1024 nt
    s_waitcnt vmcnt(11)
    global_load_dwordx4 v[88:91], v92, s[12:13] offset:2048 nt
    s_waitcnt vmcnt(11)
    global_load_dwordx4 v[92:95], v92, s[12:13] offset:3072 nt
    s_waitcnt vmcnt(11)
    global_load_dwordx4 v[96:99], v108, s[12:13] offset:0 nt
    s_waitcnt vmcnt(11)
    global_load_dwordx4 v[100:103], v108, s[12:13] offset:1024 nt
    s_waitcnt vmcnt(11)
    global_load_dwordx4 v[104:107], v108, s[12:13] offset:2048 nt
    s_waitcnt vmcnt(11)
    global_load_dwordx4 v[108:111], v108, s[12:13] offset:3072 nt
    s_waitcnt vmcnt(11)
    global_load_dwordx4 v[112:115], v124, s[12:13] offset:0 nt
    s_waitcnt vmcnt(11)
    global_load_dwordx4 v[116:119], v124, s[12:13] offset:1024 nt
    s_waitcnt vmcnt(11)
    global_load_dwordx4 v[120:123], v124, s[12:13] offset:2048 nt
    s_waitcnt vmcnt(11)
    global_load_dwordx4 v[124:127], v124, s[12:13] offset:3072 nt
    s_barrier
L_warm1:
    ds_read_b128 v[160:163], v200
    ds_read_b128 v[164:167], v201
    ds_read_b128 v[168:171], v202
    ds_read_b128 v[172:175], v203
    v_mov_b32 v13, 0
    ds_read_b32 v13, v13 offset:304
    s_waitcnt vmcnt(12) lgkmcnt(0)
    v_mfma_f32_16x16x32_bf16 v[176:179], v[16:19], v[160:163], 0
    v_mfma_f32_16x16x32_bf16 v[180:183], v[32:35], v[160:163], 0
    v_mfma_f32_16x16x32_bf16 v[184:187], v[48:51], v[160:163], 0
    v_mfma_f32_16x16x32_bf16 v[188:191], v[64:67], v[160:163], 0
    v_mfma_f32_16x16x32_bf16 v[176:179], v[20:23], v[164:167], v[176:179]
    v_mfma_f32_16x16x32_bf16 v[180:183], v[36:39], v[164:167], v[180:183]
    v_mfma_f32_16x16x32_bf16 v[184:187], v[52:55], v[164:167], v[184:187]
    v_mfma_f32_16x16x32_bf16 v[188:191], v[68:71], v[164:167], v[188:191]
    v_mfma_f32_16x16x32_bf16 v[176:179], v[24:27], v[168:171], v[176:179]
    v_mfma_f32_16x16x32_bf16 v[180:183], v[40:43], v[168:171], v[180:183]
    v_mfma_f32_16x16x32_bf16 v[184:187], v[56:59], v[168:171], v[184:187]
    v_mfma_f32_16x16x32_bf16 v[188:191], v[72:75], v[168:171], v[188:191]
    v_mfma_f32_16x16x32_bf16 v[176:179], v[28:31], v[172:175], v[176:179]
    v_mfma_f32_16x16x32_bf16 v[180:183], v[44:47], v[172:175], v[180:183]
    v_mfma_f32_16x16x32_bf16 v[184:187], v[60:63], v[172:175], v[184:187]
    v_mfma_f32_16x16x32_bf16 v[188:191], v[76:79], v[172:175], v[188:191]
    v_readfirstlane_b32 s52, v13
    s_cbranch_execz L_ws1
    global_load_dwordx4 v[128:131], v140, s[12:13] offset:0 nt
    global_load_dwordx4 v[132:135], v140, s[12:13] offset:1024 nt
L_ws1:
    s_nop 3
    v_mov_b32_dpp v8, v176 quad_perm:[0,0,0,0] row_mask:0xf bank_mask:0xf
    v_mov_b32_dpp v9, v180 quad_perm:[0,0,0,0] row_mask:0xf bank_mask:0xf
    v_mov_b32_dpp v10, v184 quad_perm:[0,0,0,0] row_mask:0xf bank_mask:0xf
    v_mov_b32_dpp v11, v188 quad_perm:[0,0,0,0] row_mask:0xf bank_mask:0xf
    v_add_f32_dpp v8, v177, v8 quad_perm:[1,1,1,1] row_mask:0xf bank_mask:0xf
    v_add_f32_dpp v9, v181, v9 quad_perm:[1,1,1,1] row_mask:0xf bank_mask:0xf
    v_add_f32_dpp v10, v185, v10 quad_perm:[1,1,1,1] row_mask:0xf bank_mask:0xf
    v_add_f32_dpp v11, v189, v11 quad_perm:[1,1,1,1] row_mask:0xf bank_mask:0xf
    v_add_f32_dpp v8, v178, v8 quad_perm:[2,2,2,2] row_mask:0xf bank_mask:0xf
    v_add_f32_dpp v9, v182, v9 quad_perm:[2,2,2,2] row_mask:0xf bank_mask:0xf
    v_add_f32_dpp v10, v186, v10 quad_perm:[2,2,2,2] row_mask:0xf bank_mask:0xf
    v_add_f32_dpp v11, v190, v11 quad_perm:[2,2,2,2] row_mask:0xf bank_mask:0xf
    v_add_f32_dpp v8, v179, v8 quad_perm:[3,3,3,3] row_mask:0xf bank_mask:0xf
    v_add_f32_dpp v9, v183, v9 quad_perm:[3,3,3,3] row_mask:0xf bank_mask:0xf
    v_add_f32_dpp v10, v187, v10 quad_perm:[3,3,3,3] row_mask:0xf bank_mask:0xf
    v_add_f32_dpp v11, v191, v11 quad_perm:[3,3,3,3] row_mask:0xf bank_mask:0xf
    v_cvt_pk_bf16_f32 v12, v8, v9
    v_cvt_pk_bf16_f32 v13, v10, v11
    v_lshlrev_b32 v8, 16, v12
    v_and_b32 v9, 0xffff0000, v12
    v_lshlrev_b32 v10, 16, v13
    v_and_b32 v11, 0xffff0000, v13
    v_mul_f32 v8, 0x3db504f3, v8
    v_mul_f32 v9, 0x3db504f3, v9
    v_mul_f32 v10, 0x3db504f3, v10
    v_mul_f32 v11, 0x3db504f3, v11
    v_cvt_pk_bf16_f32 v12, v8, v9
    v_cvt_pk_bf16_f32 v13, v10, v11
    v_lshlrev_b32 v8, 16, v12
    v_and_b32 v9, 0xffff0000, v12
    v_lshlrev_b32 v10, 16, v13
    v_and_b32 v11, 0xffff0000, v13
    v_max_f32 v12, v8, v9
    v_max3_f32 v12, v10, v11, v12
    s_nop 1
    v_max_f32_dpp v12, v12, v12 row_ror:4 row_mask:0xf bank_mask:0xf
    s_nop 1
    v_max_f32_dpp v12, v12, v12 row_ror:8 row_mask:0xf bank_mask:0xf
    s_nop 1
    v_max_f32_dpp v12, v12, v12 row_bcast:15 row_mask:0xa bank_mask:0xf
    s_nop 1
    v_max_f32_dpp v12, v12, v12 row_bcast:31 row_mask:0xc bank_mask:0xf
    s_nop 0
    v_readlane_b32 s35, v12, 63
    v_mov_b32 v13, 0
    s_nop 0
    v_mov_b32 v12, s35
    ds_write_b32 v213, v12 offset:272
    s_cbranch_execz L_ws2
    global_load_dwordx4 v[136:139], v140, s[12:13] offset:2048 nt
    global_load_dwordx4 v[140:143], v140, s[12:13] offset:3072 nt
    s_waitcnt lgkmcnt(0)
    s_barrier
L_ws2:
    ds_read_b128 v[176:179], v13 offset:272
    s_mov_b32 s35, 0x3fb8aa3b
    s_waitcnt lgkmcnt(0)
    v_max_f32 v12, v176, v177
    v_max3_f32 v12, v178, v179, v12
    v_mul_f32 v217, s35, v12
    v_fma_f32 v8, v8, s35, -v217
    v_fma_f32 v9, v9, s35, -v217
    v_fma_f32 v10, v10, s35, -v217
    v_fma_f32 v11, v11, s35, -v217
    v_exp_f32 v8, v8
    v_exp_f32 v9, v9
    v_exp_f32 v10, v10
    v_exp_f32 v11, v11
    s_cbranch_execz L_ws3
    global_load_dwordx4 v[144:147], v156, s[16:17] offset:0 nt
    global_load_dwordx4 v[148:151], v156, s[16:17] offset:1024 nt
    global_load_dwordx4 v[152:155], v156, s[16:17] offset:2048 nt
L_ws3:
    s_nop 0
    v_add_f32 v12, v8, v9
    v_add_f32 v13, v10, v11
    v_cvt_pk_bf16_f32 v8, v8, v8
    v_add_f32 v12, v12, v13
    v_cvt_pk_bf16_f32 v9, v9, v9
    v_cvt_pk_bf16_f32 v10, v10, v10
    v_add_f32_dpp v12, v12, v12 row_ror:4 row_mask:0xf bank_mask:0xf
    v_cvt_pk_bf16_f32 v11, v11, v11
    v_and_b32_dpp v16, v8, v192 row_newbcast:0 row_mask:0xf bank_mask:0xf
    v_and_b32_dpp v17, v8, v193 row_newbcast:0 row_mask:0xf bank_mask:0xf
    v_and_b32_dpp v18, v8, v194 row_newbcast:0 row_mask:0xf bank_mask:0xf
    v_and_b32_dpp v19, v8, v195 row_newbcast:0 row_mask:0xf bank_mask:0xf
    v_add_f32_dpp v12, v12, v12 row_ror:8 row_mask:0xf bank_mask:0xf
    v_and_b32_dpp v20, v8, v192 row_newbcast:4 row_mask:0xf bank_mask:0xf
    v_and_b32_dpp v21, v8, v193 row_newbcast:4 row_mask:0xf bank_mask:0xf
    v_and_b32_dpp v22, v8, v194 row_newbcast:4 row_mask:0xf bank_mask:0xf
    v_and_b32_dpp v23, v8, v195 row_newbcast:4 row_mask:0xf bank_mask:0xf
    v_add_f32_dpp v12, v12, v12 row_bcast:15 row_mask:0xa bank_mask:0xf
    v_and_b32_dpp v24, v8, v192 row_newbcast:8 row_mask:0xf bank_mask:0xf
    v_and_b32_dpp v25, v8, v193 row_newbcast:8 row_mask:0xf bank_mask:0xf
    v_and_b32_dpp v26, v8, v194 row_newbcast:8 row_mask:0xf bank_mask:0xf
    v_and_b32_dpp v27, v8, v195 row_newbcast:8 row_mask:0xf bank_mask:0xf
    v_add_f32_dpp v12, v12, v12 row_bcast:31 row_mask:0xc bank_mask:0xf
    v_and_b32_dpp v28, v8, v192 row_newbcast:12 row_mask:0xf bank_mask:0xf
    v_and_b32_dpp v29, v8, v193 row_newbcast:12 row_mask:0xf bank_mask:0xf
    v_and_b32_dpp v30, v8, v194 row_newbcast:12 row_mask:0xf bank_mask:0xf
    v_and_b32_dpp v31, v8, v195 row_newbcast:12 row_mask:0xf bank_mask:0xf
    v_readlane_b32 s35, v12, 63
    v_and_b32_dpp v32, v9, v192 row_newbcast:0 row_mask:0xf bank_mask:0xf
    v_and_b32_dpp v33, v9, v193 row_newbcast:0 row_mask:0xf bank_mask:0xf
    v_and_b32_dpp v34, v9, v194 row_newbcast:0 row_mask:0xf bank_mask:0xf
    v_and_b32_dpp v35, v9, v195 row_newbcast:0 row_mask:0xf bank_mask:0xf
    v_mov_b32 v12, s35
    v_and_b32_dpp v36, v9, v192 row_newbcast:4 row_mask:0xf bank_mask:0xf
    v_and_b32_dpp v37, v9, v193 row_newbcast:4 row_mask:0xf bank_mask:0xf
    v_and_b32_dpp v38, v9, v194 row_newbcast:4 row_mask:0xf bank_mask:0xf
    v_and_b32_dpp v39, v9, v195 row_newbcast:4 row_mask:0xf bank_mask:0xf
    ds_write_b32 v213, v12 offset:288
    v_and_b32_dpp v40, v9, v192 row_newbcast:8 row_mask:0xf bank_mask:0xf
    v_and_b32_dpp v41, v9, v193 row_newbcast:8 row_mask:0xf bank_mask:0xf
    v_and_b32_dpp v42, v9, v194 row_newbcast:8 row_mask:0xf bank_mask:0xf
    v_and_b32_dpp v43, v9, v195 row_newbcast:8 row_mask:0xf bank_mask:0xf
    v_and_b32_dpp v44, v9, v192 row_newbcast:12 row_mask:0xf bank_mask:0xf
    v_and_b32_dpp v45, v9, v193 row_newbcast:12 row_mask:0xf bank_mask:0xf
    v_and_b32_dpp v46, v9, v194 row_newbcast:12 row_mask:0xf bank_mask:0xf
    v_and_b32_dpp v47, v9, v195 row_newbcast:12 row_mask:0xf bank_mask:0xf
    s_cbranch_execz L_ws4
    global_load_dwordx4 v[156:159], v156, s[16:17] offset:3072 nt
L_ws4:
    v_and_b32_dpp v48, v10, v192 row_newbcast:0 row_mask:0xf bank_mask:0xf
    v_and_b32_dpp v49, v10, v193 row_newbcast:0 row_mask:0xf bank_mask:0xf
    v_and_b32_dpp v50, v10, v194 row_newbcast:0 row_mask:0xf bank_mask:0xf
    v_and_b32_dpp v51, v10, v195 row_newbcast:0 row_mask:0xf bank_mask:0xf
    v_and_b32_dpp v52, v10, v192 row_newbcast:4 row_mask:0xf bank_mask:0xf
    v_and_b32_dpp v53, v10, v193 row_newbcast:4 row_mask:0xf bank_mask:0xf
    v_and_b32_dpp v54, v10, v194 row_newbcast:4 row_mask:0xf bank_mask:0xf
    v_and_b32_dpp v55, v10, v195 row_newbcast:4 row_mask:0xf bank_mask:0xf
    v_and_b32_dpp v56, v10, v192 row_newbcast:8 row_mask:0xf bank_mask:0xf
    v_and_b32_dpp v57, v10, v193 row_newbcast:8 row_mask:0xf bank_mask:0xf
    v_and_b32_dpp v58, v10, v194 row_newbcast:8 row_mask:0xf bank_mask:0xf
    v_and_b32_dpp v59, v10, v195 row_newbcast:8 row_mask:0xf bank_mask:0xf
    v_and_b32_dpp v60, v10, v192 row_newbcast:12 row_mask:0xf bank_mask:0xf
    v_and_b32_dpp v61, v10, v193 row_newbcast:12 row_mask:0xf bank_mask:0xf
    v_and_b32_dpp v62, v10, v194 row_newbcast:12 row_mask:0xf bank_mask:0xf
    v_and_b32_dpp v63, v10, v195 row_newbcast:12 row_mask:0xf bank_mask:0xf
    v_and_b32_dpp v64, v11, v192 row_newbcast:0 row_mask:0xf bank_mask:0xf
    v_and_b32_dpp v65, v11, v193 row_newbcast:0 row_mask:0xf bank_mask:0xf
    v_and_b32_dpp v66, v11, v194 row_newbcast:0 row_mask:0xf bank_mask:0xf
    v_and_b32_dpp v67, v11, v195 row_newbcast:0 row_mask:0xf bank_mask:0xf
    v_and_b32_dpp v68, v11, v192 row_newbcast:4 row_mask:0xf bank_mask:0xf
    v_and_b32_dpp v69, v11, v193 row_newbcast:4 row_mask:0xf bank_mask:0xf
    v_and_b32_dpp v70, v11, v194 row_newbcast:4 row_mask:0xf bank_mask:0xf
    v_and_b32_dpp v71, v11, v195 row_newbcast:4 row_mask:0xf bank_mask:0xf
    v_and_b32_dpp v72, v11, v192 row_newbcast:8 row_mask:0xf bank_mask:0xf
    v_and_b32_dpp v73, v11, v193 row_newbcast:8 row_mask:0xf bank_mask:0xf
    v_and_b32_dpp v74, v11, v194 row_newbcast:8 row_mask:0xf bank_mask:0xf
    v_and_b32_dpp v75, v11, v195 row_newbcast:8 row_mask:0xf bank_mask:0xf
    v_and_b32_dpp v76, v11, v192 row_newbcast:12 row_mask:0xf bank_mask:0xf
    v_and_b32_dpp v77, v11, v193 row_newbcast:12 row_mask:0xf bank_mask:0xf
    v_and_b32_dpp v78, v11, v194 row_newbcast:12 row_mask:0xf bank_mask:0xf
    v_and_b32_dpp v79, v11, v195 row_newbcast:12 row_mask:0xf bank_mask:0xf
    s_waitcnt vmcnt(16)
    v_mfma_f32_16x16x32_bf16 v[220:223], v[16:19], v[80:83], 0
    v_mfma_f32_16x16x32_bf16 v[220:223], v[20:23], v[84:87], v[220:223]
    v_mfma_f32_16x16x32_bf16 v[220:223], v[24:27], v[88:91], v[220:223]
    v_mfma_f32_16x16x32_bf16 v[220:223], v[28:31], v[92:95], v[220:223]
    s_waitcnt vmcnt(12)
    v_mfma_f32_16x16x32_bf16 v[220:223], v[32:35], v[96:99], v[220:223]
    v_mfma_f32_16x16x32_bf16 v[220:223], v[36:39], v[100:103], v[220:223]
    v_mfma_f32_16x16x32_bf16 v[220:223], v[40:43], v[104:107], v[220:223]
    v_mfma_f32_16x16x32_bf16 v[220:223], v[44:47], v[108:111], v[220:223]
    s_waitcnt vmcnt(8)
    v_mfma_f32_16x16x32_bf16 v[220:223], v[48:51], v[112:115], v[220:223]
    v_mfma_f32_16x16x32_bf16 v[220:223], v[52:55], v[116:119], v[220:223]
    v_mfma_f32_16x16x32_bf16 v[220:223], v[56:59], v[120:123], v[220:223]
    v_mfma_f32_16x16x32_bf16 v[220:223], v[60:63], v[124:127], v[220:223]
    s_waitcnt vmcnt(7)
    v_mfma_f32_16x16x32_bf16 v[220:223], v[64:67], v[128:131], v[220:223]
    s_waitcnt vmcnt(6)
    v_mfma_f32_16x16x32_bf16 v[220:223], v[68:71], v[132:135], v[220:223]
    s_waitcnt vmcnt(5)
    v_mfma_f32_16x16x32_bf16 v[220:223], v[72:75], v[136:139], v[220:223]
    s_waitcnt vmcnt(4)
    v_mfma_f32_16x16x32_bf16 v[220:223], v[76:79], v[140:143], v[220:223]
    s_cmp_eq_u32 s6, 0
    v_mov_b32 v13, 0
    s_nop 5
    ds_write_b64 v207, v[220:221]
    s_waitcnt lgkmcnt(0)
    s_barrier
    s_cbranch_scc0 L_pub1
    ds_read2st64_b64 v[176:179], v207 offset0:1 offset1:2
    ds_read_b64 v[180:181], v207 offset:1536
    ds_read_b128 v[184:187], v13 offset:288
    v_mov_b32 v222, s34
    s_cmp_eq_u32 s52, 0
    s_waitcnt lgkmcnt(2)
    v_pk_add_f32 v[220:221], v[220:221], v[176:177]
    s_waitcnt lgkmcnt(1)
    v_pk_add_f32 v[178:179], v[178:179], v[180:181]
    s_waitcnt lgkmcnt(0)
    v_pk_add_f32 v[184:185], v[184:185], v[186:187]
    v_pk_add_f32 v[220:221], v[220:221], v[178:179]
    v_add_f32 v184, v184, v185
    s_cbranch_execz L_ws5
    v_cndmask_b32 v223, v217, v184, s[42:43]
    s_cbranch_scc0 L_farpub
    global_store_dwordx4 v206, v[220:223], s[32:33]
L_pub1:
    s_barrier
L_again1:
L_poll1:
    global_load_dwordx4 v[176:179], v205, s[32:33] sc1
    global_load_dwordx4 v[180:183], v205, s[32:33] offset:128 sc1
    s_sub_u32 s40, s40, 1
    s_cbranch_scc1 L_end
    s_waitcnt vmcnt(0)
    v_bitop3_b32 v8, v178, v182, s34 bitop3:0x7e
    v_cmp_ne_u32 vcc, 0, v8
    s_and_b64 exec, vcc, vcc
    s_cbranch_scc1 L_again1
    s_mov_b64 exec, -1
    s_cmp_eq_u32 s53, 1
    s_cbranch_scc0 L_nob
    global_load_dwordx4 v[228:231], v211, s[32:33] offset:-4096 sc1
    global_load_dwordx4 v[232:235], v211, s[32:33] sc1
    global_load_dwordx4 v[236:239], v212, s[32:33] offset:-4096 sc1
    global_load_dwordx4 v[240:243], v212, s[32:33] sc1
L_nob:
L_ws5:
    v_max_f32_dpp v8, v179, v179 quad_perm:[1,0,3,2] row_mask:0xf bank_mask:0xf
    s_nop 1
    v_max_f32_dpp v8, v8, v8 quad_perm:[2,3,0,1] row_mask:0xf bank_mask:0xf
    s_nop 1
    v_max_f32_dpp v8, v8, v8 row_half_mirror row_mask:0xf bank_mask:0xf
    v_sub_f32 v8, v179, v8
    v_exp_f32 v8, v8
    s_cmp_eq_u32 s6, 0
    v_mul_f32 v183, v8, v183
    v_pk_mul_f32 v[176:177], v[8:9], v[176:177] op_sel_hi:[0,1]
    v_pk_mul_f32 v[180:181], v[8:9], v[180:181] op_sel_hi:[0,1]
    v_add_f32_dpp v183, v183, v183 quad_perm:[1,0,3,2] row_mask:0xf bank_mask:0xf
    v_add_f32_dpp v176, v176, v176 quad_perm:[1,0,3,2] row_mask:0xf bank_mask:0xf
    v_add_f32_dpp v177, v177, v177 quad_perm:[1,0,3,2] row_mask:0xf bank_mask:0xf
    v_add_f32_dpp v180, v180, v180 quad_perm:[1,0,3,2] row_mask:0xf bank_mask:0xf
    v_add_f32_dpp v181, v181, v181 quad_perm:[1,0,3,2] row_mask:0xf bank_mask:0xf
    v_add_f32_dpp v183, v183, v183 quad_perm:[2,3,0,1] row_mask:0xf bank_mask:0xf
    v_add_f32_dpp v176, v176, v176 quad_perm:[2,3,0,1] row_mask:0xf bank_mask:0xf
    v_add_f32_dpp v177, v177, v177 quad_perm:[2,3,0,1] row_mask:0xf bank_mask:0xf
    v_add_f32_dpp v180, v180, v180 quad_perm:[2,3,0,1] row_mask:0xf bank_mask:0xf
    v_add_f32_dpp v181, v181, v181 quad_perm:[2,3,0,1] row_mask:0xf bank_mask:0xf
    v_add_f32_dpp v183, v183, v183 row_half_mirror row_mask:0xf bank_mask:0xf
    v_add_f32_dpp v176, v176, v176 row_half_mirror row_mask:0xf bank_mask:0xf
    v_add_f32_dpp v177, v177, v177 row_half_mirror row_mask:0xf bank_mask:0xf
    v_rcp_f32 v8, v183
    v_add_f32_dpp v180, v180, v180 row_half_mirror row_mask:0xf bank_mask:0xf
    v_add_f32_dpp v181, v181, v181 row_half_mirror row_mask:0xf bank_mask:0xf
    v_pk_mul_f32 v[176:177], v[8:9], v[176:177] op_sel_hi:[0,1]
    v_pk_mul_f32 v[180:181], v[8:9], v[180:181] op_sel_hi:[0,1]
    v_mov_b32 v9, s34
    v_cvt_pk_bf16_f32 v176, v176, v176
    v_cvt_pk_bf16_f32 v177, v177, v177
    v_cvt_pk_bf16_f32 v180, v180, v180
    v_cvt_pk_bf16_f32 v181, v181, v181
    v_and_b32 v16, v176, v196
    v_and_b32 v17, v176, v197
    v_and_b32 v18, v176, v198
    v_and_b32 v19, v176, v199
    v_and_b32 v20, v177, v196
    v_and_b32 v21, v177, v197
    v_and_b32 v22, v177, v198
    v_and_b32 v23, v177, v199
    v_mfma_f32_16x16x32_bf16 v[224:227], v[16:19], v[144:147], 0
    v_and_b32 v24, v180, v196
    v_and_b32 v25, v180, v197
    v_and_b32 v26, v180, v198
    v_and_b32 v27, v180, v199
    v_mfma_f32_16x16x32_bf16 v[224:227], v[20:23], v[148:151], v[224:227]
    v_and_b32 v28, v181, v196
    v_and_b32 v29, v181, v197
    v_and_b32 v30, v181, v198
    v_and_b32 v31, v181, v199
    v_mfma_f32_16x16x32_bf16 v[224:227], v[24:27], v[152:155], v[224:227]
    s_nop 0
    v_mfma_f32_16x16x32_bf16 v[224:227], v[28:31], v[156:159], v[224:227]
    s_cbranch_execz L_ws6
    s_nop 6
    ds_write_b128 v208, v[224:227]
    s_waitcnt lgkmcnt(0)
    s_barrier
    s_cbranch_scc0 L_notw0
L_ws6:
    ds_read_b32 v176, v209 offset:0
    ds_read_b32 v177, v209 offset:768
    ds_read_b32 v178, v209 offset:1280
    ds_read_b32 v179, v209 offset:2048
    ds_read_b32 v180, v209 offset:2560
    ds_read_b32 v181, v209 offset:3328
    ds_read_b32 v182, v209 offset:3840
    ds_read_b32 v183, v209 offset:4608
    s_cbranch_execz L_warm2
    s_waitcnt lgkmcnt(4)
    v_pk_add_f32 v[176:177], v[176:177], v[178:179]
    s_waitcnt lgkmcnt(0)
    v_pk_add_f32 v[180:181], v[180:181], v[182:183]
    v_pk_add_f32 v[176:177], v[176:177], v[180:181]
    v_add_f32 v8, v176, v177
    global_store_dwordx2 v210, v[8:9], s[32:33] sc1
    s_endpgm
L_notw0:
    s_cmp_eq_u32 s53, 1
    s_cbranch_scc0 L_done
L_warm2:
    s_cbranch_execz L_ws7
    global_load_dwordx4 v[16:19], v218, s[32:33] offset:-4096 sc1
    global_load_dwordx4 v[20:23], v218, s[32:33] sc1
    global_load_dwordx4 v[24:27], v219, s[32:33] offset:-4096 sc1
    global_load_dwordx4 v[28:31], v219, s[32:33] sc1
L_ws7:
    v_lshlrev_b32 v214, 16, v214
    v_lshlrev_b32 v215, 16, v215
    s_waitcnt vmcnt(4)
L_chkb:
    v_bitop3_b32 v8, v229, v231, s34 bitop3:0x7e
    v_bitop3_b32 v9, v233, v235, s34 bitop3:0x7e
    v_add_f32 v228, v228, v232
    v_add_f32 v230, v230, v234
    v_bitop3_b32 v10, v237, v239, s34 bitop3:0x7e
    v_bitop3_b32 v11, v241, v243, s34 bitop3:0x7e
    v_or3_b32 v8, v8, v9, v10
    v_or_b32 v8, v8, v11
    v_cmp_ne_u32 vcc, 0, v8
    v_add_f32 v236, v236, v240
    v_add_f32 v238, v238, v242
    v_add_f32 v228, v228, v236
    v_add_f32 v230, v230, v238
    s_cbranch_vccnz L_retryb
    v_add_f32_dpp v228, v228, v228 row_ror:8 row_mask:0xf bank_mask:0xf
    v_add_f32_dpp v230, v230, v230 row_ror:8 row_mask:0xf bank_mask:0xf
    s_nop 1
    v_permlane16_swap_b32 v228, v230
    v_add_f32 v228, v228, v230
    v_mov_b32 v230, v228
    s_nop 1
    v_permlane32_swap_b32 v228, v230
    v_add_f32 v228, v228, v230
    v_cvt_pk_bf16_f32 v228, v228, v228
    v_and_b32 v228, 0xffff0000, v228
    v_add_f32 v228, v228, v215
    v_cvt_pk_bf16_f32 v228, v228, v228
    v_and_b32 v228, 0xffff0000, v228
    v_mul_f32 v8, 0xbfb8aa3b, v228
    v_exp_f32 v8, v8
    s_nop 0
    v_add_f32 v8, 1.0, v8
    v_rcp_f32 v8, v8
    s_nop 0
    v_mul_f32 v215, v228, v8
    v_cvt_pk_bf16_f32 v215, v215, v215
    v_and_b32 v215, 0xffff0000, v215
    s_cbranch_execz L_ws8
L_poll2:
    global_load_dwordx4 v[32:35], v218, s[32:33] offset:-4096 sc1
    global_load_dwordx4 v[36:39], v218, s[32:33] sc1
    global_load_dwordx4 v[40:43], v219, s[32:33] offset:-4096 sc1
    global_load_dwordx4 v[44:47], v219, s[32:33] sc1
    s_sub_u32 s40, s40, 1
    s_cbranch_scc1 L_end
    s_waitcnt vmcnt(4)
    v_bitop3_b32 v8, v17, v19, s34 bitop3:0x7e
    v_bitop3_b32 v9, v21, v23, s34 bitop3:0x7e
    v_bitop3_b32 v10, v25, v27, s34 bitop3:0x7e
    v_bitop3_b32 v11, v29, v31, s34 bitop3:0x7e
    v_or3_b32 v8, v8, v9, v10
    v_or_b32 v8, v8, v11
    v_cmp_ne_u32 vcc, 0, v8
    v_add_f32 v176, v16, v20
    v_add_f32 v178, v18, v22
    v_add_f32 v184, v24, v28
    v_add_f32 v186, v26, v30
    s_cbranch_vccz L_ydone
    global_load_dwordx4 v[16:19], v218, s[32:33] offset:-4096 sc1
    global_load_dwordx4 v[20:23], v218, s[32:33] sc1
    global_load_dwordx4 v[24:27], v219, s[32:33] offset:-4096 sc1
    global_load_dwordx4 v[28:31], v219, s[32:33] sc1
    s_waitcnt vmcnt(4)
L_ws8:
    v_bitop3_b32 v8, v33, v35, s34 bitop3:0x7e
    v_bitop3_b32 v9, v37, v39, s34 bitop3:0x7e
    v_bitop3_b32 v10, v41, v43, s34 bitop3:0x7e
    v_bitop3_b32 v11, v45, v47, s34 bitop3:0x7e
    v_or3_b32 v8, v8, v9, v10
    v_or_b32 v8, v8, v11
    v_cmp_ne_u32 vcc, 0, v8
    v_add_f32 v176, v32, v36
    v_add_f32 v178, v34, v38
    v_add_f32 v184, v40, v44
    v_add_f32 v186, v42, v46
    s_cbranch_vccnz L_poll2
L_ydone:
    v_add_f32 v176, v176, v184
    v_add_f32 v178, v178, v186
    s_nop 0
    v_add_f32_dpp v176, v176, v176 row_ror:8 row_mask:0xf bank_mask:0xf
    v_add_f32_dpp v178, v178, v178 row_ror:8 row_mask:0xf bank_mask:0xf
    s_nop 1
    v_permlane16_swap_b32 v176, v178
    v_add_f32 v176, v176, v178
    v_mov_b32 v178, v176
    s_nop 1
    v_permlane32_swap_b32 v176, v178
    v_add_f32 v176, v176, v178
    v_cvt_pk_bf16_f32 v176, v176, v176
    v_and_b32 v176, 0xffff0000, v176
    v_mul_f32 v176, v176, v215
    v_cvt_pk_bf16_f32 v176, v176, v176
    v_and_b32 v176, 0xffff0000, v176
    v_add_f32 v176, v176, v214
    s_cbranch_execz L_warm3
    v_cvt_pk_bf16_f32 v176, v176, v176
    s_mov_b64 exec, 0x00ff00ff
    global_store_short v204, v176, s[28:29]
    s_cmp_eq_u32 s2, 0
    s_cbranch_scc0 L_done
    v_mov_b32 v8, 0
    v_mov_b32 v9, s34
    s_mov_b64 exec, 1
    global_store_dword v8, v9, s[32:33]
L_done:
L_end:
    s_endpgm
L_retryb:
    global_load_dwordx4 v[228:231], v211, s[32:33] offset:-4096 sc1
    global_load_dwordx4 v[232:235], v211, s[32:33] sc1
    global_load_dwordx4 v[236:239], v212, s[32:33] offset:-4096 sc1
    global_load_dwordx4 v[240:243], v212, s[32:33] sc1
    s_sub_u32 s40, s40, 1
    s_cbranch_scc1 L_end
    s_waitcnt vmcnt(0)
    s_branch L_chkb
L_farpub:
    global_store_dwordx4 v206, v[220:223], s[32:33] sc1
    s_branch L_pub1
L_codeend:
.section .rodata,"a"
.p2align 6
.amdhsa_kernel recurrent_scan__sliding_block_cached__mixer_channel_mlp__decode_kernel
  .amdhsa_next_free_vgpr 244
  .amdhsa_next_free_sgpr 64
  .amdhsa_accum_offset 244
  .amdhsa_group_segment_fixed_size 0
  .amdhsa_kernarg_size 104
  .amdhsa_user_sgpr_count 2
  .amdhsa_user_sgpr_kernarg_segment_ptr 1
  .amdhsa_system_sgpr_workgroup_id_x 1
  .amdhsa_float_denorm_mode_32 3
.end_amdhsa_kernel
```
